```python
import torch

def _softmax(x, axis=-1):
    return torch.softmax(x, dim=axis)
def _gelu(x):
    return torch.nn.functional.gelu(x, approximate="tanh")
def _silu(x):
    return torch.nn.functional.silu(x)
def _sigmoid(x):
    return torch.sigmoid(x)
def _layernorm(x, axis=-1, eps=1e-5):
    m = x.mean(dim=axis, keepdim=True)
    v = x.var(dim=axis, keepdim=True, unbiased=False)
    return (x - m) / torch.sqrt(v + eps)
def _scatter_add(tgt, idx, src, axis=0):
    return tgt.clone().index_add_(axis, idx, src)
def _segment_sum(src, seg, n):
    out = torch.zeros((n,) + src.shape[1:], dtype=src.dtype)
    return out.index_add_(0, seg, src)
def _pad(x, pw):
    flat = tuple(v for pair in reversed(pw) for v in pair)
    return torch.nn.functional.pad(x, flat)

kernel_name = 'concat_heads__sliding_block_cached__sliding_block_cached__decode'

def setup_inputs():

    _w = (lambda a: (lambda t: t.to(torch.bfloat16) if t.is_floating_point() else t)(torch.as_tensor(a)))
    def _A_setup():
        B, Sq, D = 1, 1, 512
        Hq, Hkv, Sk, Dh = 32, 8, 32768, 128
        assert Hq % Hkv == 0, (Hq, Hkv)
        return {
            "x": _w((lambda *s: torch.randn(*s, dtype=torch.bfloat16) * 0.8)(B, Sq, D)),
            "k_cache": _w((lambda *s: torch.randn(*s, dtype=torch.bfloat16) * 0.8)(B, Hkv, Sk, Dh)),
            "v_cache": _w((lambda *s: torch.randn(*s, dtype=torch.bfloat16) * 0.05)(B, Hkv, Sk, Dh)),
            "wq": _w((lambda *s: torch.randn(*s, dtype=torch.bfloat16) * 0.8)(D, Hq * Dh) * (D ** -0.5)),
            "wo": _w((lambda *s: torch.randn(*s, dtype=torch.bfloat16) * 0.05)(Hq * Dh, D) * ((Hq * Dh) ** -0.5)),
        }
    _A_in = _A_setup()

    def _B_setup():
        B, Sq, D = 1, 1, 512
        Hq, Hkv, Sk, Dh = 32, 8, 32768, 128
        assert Hq % Hkv == 0, (Hq, Hkv)
        return {
            "x": _w((lambda *s: torch.randn(*s, dtype=torch.bfloat16) * 0.8)(B, Sq, D)),
            "k_cache": _w((lambda *s: torch.randn(*s, dtype=torch.bfloat16) * 0.8)(B, Hkv, Sk, Dh)),
            "v_cache": _w((lambda *s: torch.randn(*s, dtype=torch.bfloat16) * 0.05)(B, Hkv, Sk, Dh)),
            "wq": _w((lambda *s: torch.randn(*s, dtype=torch.bfloat16) * 0.8)(D, Hq * Dh) * (D ** -0.5)),
            "wo": _w((lambda *s: torch.randn(*s, dtype=torch.bfloat16) * 0.05)(Hq * Dh, D) * ((Hq * Dh) ** -0.5)),
        }
    _B_in = _B_setup()

    return {
        "A_x": _A_in["x"],
        "A_k_cache": _A_in["k_cache"],
        "A_v_cache": _A_in["v_cache"],
        "A_wq": _A_in["wq"],
        "A_wo": _A_in["wo"],
        "B_x": _B_in["x"],
        "B_k_cache": _B_in["k_cache"],
        "B_v_cache": _B_in["v_cache"],
        "B_wq": _B_in["wq"],
        "B_wo": _B_in["wo"],
    }

def reference(A_x, A_k_cache, A_v_cache, A_wq, A_wo, B_x, B_k_cache, B_v_cache, B_wq, B_wo):
    def _A_ref(x, k_cache, v_cache, wq, wo):
        B, Sq, D = x.shape
        Hq, Dh = 32, 128
        Hkv, Sk = k_cache.shape[1], k_cache.shape[2]
        W = min(4096, max(256, Sk // 4))
        rep = Hq // Hkv
        q = (lambda x, *d: x.permute(*d))((x @ wq).reshape(B, Sq, Hq, Dh), 0, 2, 1, 3)
        k = (lambda x, n, axis: torch.repeat_interleave(x, n, dim=axis))(k_cache[:, :, Sk - W:, :], rep, axis=1)
        v = (lambda x, n, axis: torch.repeat_interleave(x, n, dim=axis))(v_cache[:, :, Sk - W:, :], rep, axis=1)
        scores = torch.einsum("bhqd,bhkd->bhqk", q, k) * (Dh ** -0.5)
        p = _softmax(scores, axis=-1)
        o = torch.einsum("bhqk,bhkd->bhqd", p, v)
        return (lambda x, *d: x.permute(*d))(o, 0, 2, 1, 3).reshape(B, Sq, Hq * Dh) @ wo

    def _B_ref(x, k_cache, v_cache, wq, wo):
        B, Sq, D = x.shape
        Hq, Dh = 32, 128
        Hkv, Sk = k_cache.shape[1], k_cache.shape[2]
        W = min(4096, max(256, Sk // 4))
        rep = Hq // Hkv
        q = (lambda x, *d: x.permute(*d))((x @ wq).reshape(B, Sq, Hq, Dh), 0, 2, 1, 3)
        k = (lambda x, n, axis: torch.repeat_interleave(x, n, dim=axis))(k_cache[:, :, Sk - W:, :], rep, axis=1)
        v = (lambda x, n, axis: torch.repeat_interleave(x, n, dim=axis))(v_cache[:, :, Sk - W:, :], rep, axis=1)
        scores = torch.einsum("bhqd,bhkd->bhqk", q, k) * (Dh ** -0.5)
        p = _softmax(scores, axis=-1)
        o = torch.einsum("bhqk,bhkd->bhqd", p, v)
        return (lambda x, *d: x.permute(*d))(o, 0, 2, 1, 3).reshape(B, Sq, Hq * Dh) @ wo

    a = _A_ref(A_x, A_k_cache, A_v_cache, A_wq, A_wo)
    b = _B_ref(B_x, B_k_cache, B_v_cache, B_wq, B_wo)
    return torch.concatenate([a, b], axis=-1)
```

```asm
; @launch grid=(256,1,1) block=(768,1,1) lds=38912
.amdgcn_target "amdgcn-amd-amdhsa--gfx950"
.text
.globl concat_heads__sliding_block_cached__sliding_block_cached__decode_kernel
.p2align 8
.type concat_heads__sliding_block_cached__sliding_block_cached__decode_kernel,@function
concat_heads__sliding_block_cached__sliding_block_cached__decode_kernel:
    s_and_b32 s14, s2, 8
    s_mul_i32 s15, s14, 5
    s_load_dwordx8 s[4:11], s[0:1], s15
    s_load_dwordx2 s[12:13], s[0:1], s15 offset:32
    s_load_dwordx2 s[20:21], s[0:1], 96
    s_load_dwordx2 s[16:17], s[0:1], 80
    s_cmp_ge_u32 s2, 256
    s_cbranch_scc1 L_end
    v_lshrrev_b32 v1, 6, v0
    s_lshr_b32 s24, s2, 4
    v_readfirstlane_b32 s3, v1
    s_and_b32 s25, s2, 7
    s_lshl_b32 s33, s14, 5
    v_and_b32 v1, 63, v0
    v_lshlrev_b32 v2, 4, v1
    s_cmp_ge_u32 s3, 4
    s_cbranch_scc1 L_kv
    v_lshrrev_b32 v9, 4, v0
    v_and_b32 v8, 0xf0, v2
    v_lshl_or_b32 v11, v9, 16, v8
    v_lshlrev_b32 v10, 4, v9
    s_lshr_b32 s32, s24, 2
    s_lshl_b32 s35, s32, 8
    s_lshl_b32 s32, s32, 20
    s_lshl_b32 s31, s25, 10
    s_add_u32 s31, s31, s32
    s_and_b32 s32, s24, 3
    s_lshl_b32 s32, s32, 8
    s_add_u32 s31, s31, s32
    v_add_u32 v10, s35, v10
    s_movk_i32 s34, 0x2000
    s_lshl_b32 s36, s25, 2
    s_add_u32 s36, s36, s3
    s_cmp_eq_u32 s36, 1
    s_waitcnt lgkmcnt(0)
    s_cbranch_scc1 L_zero0
L_zero0_back:
    s_add_u32 s10, s10, s31
    s_addc_u32 s11, s11, 0
    global_load_dwordx4 v[12:15], v10, s[4:5]
    global_load_dwordx4 v[16:19], v11, s[10:11] nt
    v_add_u32 v11, s34, v11
    global_load_dwordx4 v[20:23], v11, s[10:11] nt
    v_add_u32 v11, s34, v11
    global_load_dwordx4 v[24:27], v11, s[10:11] nt
    v_add_u32 v11, s34, v11
    global_load_dwordx4 v[28:31], v11, s[10:11] nt
    v_add_u32 v11, s34, v11
    global_load_dwordx4 v[32:35], v11, s[10:11] nt
    v_add_u32 v11, s34, v11
    global_load_dwordx4 v[36:39], v11, s[10:11] nt
    v_add_u32 v11, s34, v11
    global_load_dwordx4 v[40:43], v11, s[10:11] nt
    v_add_u32 v11, s34, v11
    global_load_dwordx4 v[44:47], v11, s[10:11] nt
    s_load_dword s22, s[20:21], s33
    s_barrier
    s_branch L_q2
L_zero0:
    s_lshr_b32 s35, s33, 3
    s_lshl_b32 s36, s24, 1
    s_add_u32 s35, s35, s36
    v_lshrrev_b32 v3, 5, v1
    v_add_u32 v3, s35, v3
    v_mul_u32_u24 v3, 128, v3
    v_and_b32 v4, 31, v1
    v_lshl_add_u32 v3, v4, 2, v3
    v_add_u32 v3, 1638400, v3
    v_mov_b32 v4, 0
    global_store_dword v3, v4, s[20:21] sc1
    s_branch L_zero0_back
L_kv:
    v_lshlrev_b32 v9, 7, v1
    s_cmp_lg_u32 s3, 5
    s_cbranch_scc1 L_nopre
    s_getpc_b64 s[28:29]
L_pc:
    v_min_u32 v4, L_end-L_pc, v9
    global_load_dword v31, v4, s[28:29]
L_nopre:
    s_sub_u32 s41, s3, 4
    s_and_b32 s26, s2, 15
    s_mul_i32 s26, s26, 47104
    s_add_u32 s26, s26, 65536
    v_and_b32 v8, 0x30, v2
    v_and_b32 v15, 12, v1
    v_lshl_or_b32 v6, v15, 6, v8
    v_and_b32 v15, 48, v1
    v_lshl_or_b32 v6, v15, 2, v6
    s_lshl_b32 s30, s25, 23
    s_lshl_b32 s31, s24, 16
    s_add_u32 s30, s30, s31
    s_lshl_b32 s31, s41, 13
    s_add_u32 s30, s30, s31
    s_add_u32 s30, s30, 7340032
    s_cmp_lg_u32 s3, 4
    s_waitcnt lgkmcnt(0)
    s_cbranch_scc1 L_notouch
    s_mul_i32 s27, s24, 2944
    s_add_u32 s27, s27, s26
    v_lshlrev_b32 v3, 2, v1
    v_mov_b32 v4, 0
    s_add_u32 s35, s27, 786432
    v_min_u32 v9, 2688, v9
    v_add_u32 v9, s35, v9
    ds_write_b32 v3, v4 offset:3072
    global_load_dword v31, v9, s[20:21]
    s_waitcnt lgkmcnt(0)
L_notouch:
    s_add_u32 s6, s6, s30
    s_addc_u32 s7, s7, 0
    s_add_u32 s8, s8, s30
    s_addc_u32 s9, s9, 0
    s_load_dword s22, s[20:21], s33
    v_mov_b32 v14, 0
    s_movk_i32 s5, 1024
    s_mov_b32 s10, 8191
    s_add_u32 s4, s24, s25
    s_add_u32 s4, s4, s41
    s_lshl_b32 s4, s4, 10
    s_and_b32 s4, s4, s10
    s_barrier
    v_add_u32 v30, s4, v6
    global_load_dwordx4 v[32:35], v30, s[6:7] nt
    s_add_u32 s4, s4, s5
    s_and_b32 s4, s4, s10
    v_add_u32 v30, s4, v6
    global_load_dwordx4 v[36:39], v30, s[6:7] nt
    s_add_u32 s4, s4, s5
    s_and_b32 s4, s4, s10
    v_add_u32 v30, s4, v6
    global_load_dwordx4 v[40:43], v30, s[6:7] nt
    s_add_u32 s4, s4, s5
    s_and_b32 s4, s4, s10
    s_setprio 2
    v_mov_b32 v15, 1
    s_mov_b64 s[28:29], 0xffff
    v_lshlrev_b64 v[4:5], v8, s[28:29]
    s_add_u32 s18, s20, 786432
    s_addc_u32 s19, s21, 0
    v_subrev_u32 v0, 0x100, v0
    s_lshl_b32 s35, s41, 2
    v_and_b32 v11, 12, v1
    v_lshl_add_u32 v11, v11, 3, s35
    v_and_b32 v21, 48, v1
    v_lshl_add_u32 v7, v21, 1, s35
    v_mov_b32 v120, 0x3f803f80
    v_mov_b32 v121, v120
    v_mov_b32 v122, v120
    v_mov_b32 v123, v120
    s_mov_b32 s34, 0x3fb8aa3b
    s_mov_b32 s28, 0x3db504f3
    s_mov_b32 s29, 0xffff0000
    s_lshr_b32 s36, s24, 2
    s_lshl_b32 s32, s25, 2
    s_add_u32 s42, s32, s36
    s_lshl_b32 s32, s42, 17
    s_lshl_b32 s35, s41, 14
    s_add_u32 s32, s32, s35
    s_add_u32 s43, s24, 2
    s_and_b32 s43, s43, 3
    s_lshl_b32 s35, s43, 8
    s_add_u32 s32, s32, s35
    s_add_u32 s12, s12, s32
    s_addc_u32 s13, s13, 0
    v_and_b32 v20, 0xf0, v2
    v_lshl_or_b32 v22, v21, 8, v20
    s_lshl_b32 s35, s41, 11
    v_lshl_add_u32 v10, v1, 5, s35
    s_mul_i32 s35, s41, 2304
    v_lshl_add_u32 v23, v1, 5, s35
    v_lshl_add_u32 v23, v21, 1, v23
    v_lshrrev_b32 v12, 7, v0
    v_lshlrev_b32 v12, 5, v12
    v_lshrrev_b32 v13, 5, v0
    v_mul_u32_u24 v13, 2944, v13
    v_and_b32 v3, 16, v0
    v_lshl_add_u32 v13, v3, 6, v13
    v_lshrrev_b32 v3, 2, v20
    s_lshl_b32 s35, s24, 6
    s_add_u32 s35, s35, s26
    v_add3_u32 v13, v13, v3, s35
    s_lshr_b32 s35, s41, 1
    s_and_b32 s32, s24, 12
    s_add_u32 s35, s35, s32
    s_mul_i32 s35, s35, 2944
    s_and_b32 s32, s41, 1
    s_lshl_b32 s32, s32, 10
    s_add_u32 s35, s35, s32
    s_add_u32 s35, s35, s26
    v_lshl_add_u32 v8, v20, 2, v21
    v_add_u32 v8, s35, v8
    s_mul_i32 s36, s36, 2944
    s_add_u32 s36, s36, s26
    v_add_u32 v9, s36, v20
    v_and_b32 v3, 3, v0
    v_mul_u32_u24 v24, 544, v3
    v_and_b32 v3, 0x1fc, v0
    v_add_u32 v24, v24, v3
    s_lshl_b32 s32, s43, 8
    s_lshl_b32 s35, s33, 2
    s_add_u32 s32, s32, s35
    v_lshrrev_b32 v26, 1, v3
    v_add_u32 v26, s32, v26
    v_lshrrev_b32 v1, 5, v26
    v_mul_u32_u24 v1, 128, v1
    v_and_b32 v3, 0x3c, v0
    v_lshl_add_u32 v1, v3, 1, v1
    v_and_b32 v3, 1, v0
    v_lshl_add_u32 v1, v3, 2, v1
    v_add_u32 v1, 1638400, v1
    v_lshlrev_b32 v0, 2, v0
    s_mov_b32 s30, 0xaaaaaaaa
    s_mov_b32 s31, s30
    s_movk_i32 s37, 0xfff
    s_mov_b32 s38, 0x05040100
    s_mov_b32 s39, 0x07060302
    s_waitcnt vmcnt(2)
    v_add_u32 v30, s4, v6
    global_load_dwordx4 v[44:47], v30, s[6:7] nt
    s_add_u32 s4, s4, s5
    s_and_b32 s4, s4, s10
    s_waitcnt vmcnt(2)
    v_add_u32 v30, s4, v6
    global_load_dwordx4 v[48:51], v30, s[6:7] nt
    s_add_u32 s4, s4, s5
    s_and_b32 s4, s4, s10
    s_waitcnt vmcnt(2)
    v_add_u32 v30, s4, v6
    global_load_dwordx4 v[52:55], v30, s[6:7] nt
    s_add_u32 s4, s4, s5
    s_and_b32 s4, s4, s10
    s_waitcnt vmcnt(2)
    v_add_u32 v30, s4, v6
    global_load_dwordx4 v[56:59], v30, s[6:7] nt
    s_add_u32 s4, s4, s5
    s_and_b32 s4, s4, s10
    s_waitcnt vmcnt(2)
    v_add_u32 v30, s4, v6
    global_load_dwordx4 v[60:63], v30, s[6:7] nt
    s_add_u32 s4, s4, s5
    s_and_b32 s4, s4, s10
    s_waitcnt vmcnt(2)
    v_add_u32 v30, s4, v2
    global_load_dwordx4 v[64:67], v30, s[8:9] nt
    s_add_u32 s4, s4, s5
    s_and_b32 s4, s4, s10
    s_waitcnt vmcnt(2)
    v_add_u32 v30, s4, v2
    global_load_dwordx4 v[68:71], v30, s[8:9] nt
    s_add_u32 s4, s4, s5
    s_and_b32 s4, s4, s10
    s_waitcnt vmcnt(2)
    v_add_u32 v30, s4, v2
    global_load_dwordx4 v[72:75], v30, s[8:9] nt
    s_add_u32 s4, s4, s5
    s_and_b32 s4, s4, s10
    s_waitcnt vmcnt(2)
    v_add_u32 v30, s4, v2
    global_load_dwordx4 v[76:79], v30, s[8:9] nt
    s_add_u32 s4, s4, s5
    s_and_b32 s4, s4, s10
    s_waitcnt vmcnt(3)
    v_add_u32 v30, s4, v2
    global_load_dwordx4 v[80:83], v30, s[8:9] nt
    s_add_u32 s4, s4, s5
    s_and_b32 s4, s4, s10
    s_waitcnt vmcnt(5)
    s_mov_b32 s40, 2000000
L_qwait:
    ds_read_b32 v3, v14 offset:3200
    ds_read_b128 v[16:19], v6 offset:2048
    s_sub_u32 s40, s40, 1
    s_cbranch_scc1 L_qwait_done
    s_waitcnt lgkmcnt(0)
    v_cmp_eq_u32 vcc, 0, v3
    s_cbranch_vccz L_qwait_done
    s_sleep 2
    s_branch L_qwait
L_qwait_done:
    v_readfirstlane_b32 s45, v3
    v_mfma_f32_16x16x32_bf16 v[32:35], v[32:35], v[16:19], 0
    v_mfma_f32_16x16x32_bf16 v[36:39], v[36:39], v[16:19], 0
    v_mfma_f32_16x16x32_bf16 v[40:43], v[40:43], v[16:19], 0
    v_mfma_f32_16x16x32_bf16 v[44:47], v[44:47], v[16:19], 0
    v_mfma_f32_16x16x32_bf16 v[48:51], v[48:51], v[16:19], 0
    v_mfma_f32_16x16x32_bf16 v[52:55], v[52:55], v[16:19], 0
    v_mfma_f32_16x16x32_bf16 v[56:59], v[56:59], v[16:19], 0
    v_mfma_f32_16x16x32_bf16 v[60:63], v[60:63], v[16:19], 0
    s_nop 0
    v_mov_b32_dpp v112, v32 quad_perm:[0,0,0,0] row_mask:0xf bank_mask:0xf
    v_mov_b32_dpp v113, v36 quad_perm:[0,0,0,0] row_mask:0xf bank_mask:0xf
    v_mov_b32_dpp v114, v40 quad_perm:[0,0,0,0] row_mask:0xf bank_mask:0xf
    v_mov_b32_dpp v115, v44 quad_perm:[0,0,0,0] row_mask:0xf bank_mask:0xf
    v_mov_b32_dpp v116, v48 quad_perm:[0,0,0,0] row_mask:0xf bank_mask:0xf
    v_mov_b32_dpp v117, v52 quad_perm:[0,0,0,0] row_mask:0xf bank_mask:0xf
    v_mov_b32_dpp v118, v56 quad_perm:[0,0,0,0] row_mask:0xf bank_mask:0xf
    v_mov_b32_dpp v119, v60 quad_perm:[0,0,0,0] row_mask:0xf bank_mask:0xf
    v_add_f32_dpp v112, v33, v112 quad_perm:[1,1,1,1] row_mask:0xf bank_mask:0xf
    v_add_f32_dpp v113, v37, v113 quad_perm:[1,1,1,1] row_mask:0xf bank_mask:0xf
    v_add_f32_dpp v114, v41, v114 quad_perm:[1,1,1,1] row_mask:0xf bank_mask:0xf
    v_add_f32_dpp v115, v45, v115 quad_perm:[1,1,1,1] row_mask:0xf bank_mask:0xf
    v_add_f32_dpp v116, v49, v116 quad_perm:[1,1,1,1] row_mask:0xf bank_mask:0xf
    v_add_f32_dpp v117, v53, v117 quad_perm:[1,1,1,1] row_mask:0xf bank_mask:0xf
    v_add_f32_dpp v118, v57, v118 quad_perm:[1,1,1,1] row_mask:0xf bank_mask:0xf
    v_add_f32_dpp v119, v61, v119 quad_perm:[1,1,1,1] row_mask:0xf bank_mask:0xf
    v_add_f32_dpp v112, v34, v112 quad_perm:[2,2,2,2] row_mask:0xf bank_mask:0xf
    v_add_f32_dpp v113, v38, v113 quad_perm:[2,2,2,2] row_mask:0xf bank_mask:0xf
    v_add_f32_dpp v114, v42, v114 quad_perm:[2,2,2,2] row_mask:0xf bank_mask:0xf
    v_add_f32_dpp v115, v46, v115 quad_perm:[2,2,2,2] row_mask:0xf bank_mask:0xf
    v_add_f32_dpp v116, v50, v116 quad_perm:[2,2,2,2] row_mask:0xf bank_mask:0xf
    v_add_f32_dpp v117, v54, v117 quad_perm:[2,2,2,2] row_mask:0xf bank_mask:0xf
    v_add_f32_dpp v118, v58, v118 quad_perm:[2,2,2,2] row_mask:0xf bank_mask:0xf
    v_add_f32_dpp v119, v62, v119 quad_perm:[2,2,2,2] row_mask:0xf bank_mask:0xf
    v_add_f32_dpp v112, v35, v112 quad_perm:[3,3,3,3] row_mask:0xf bank_mask:0xf
    v_add_f32_dpp v113, v39, v113 quad_perm:[3,3,3,3] row_mask:0xf bank_mask:0xf
    v_add_f32_dpp v114, v43, v114 quad_perm:[3,3,3,3] row_mask:0xf bank_mask:0xf
    v_add_f32_dpp v115, v47, v115 quad_perm:[3,3,3,3] row_mask:0xf bank_mask:0xf
    v_add_f32_dpp v116, v51, v116 quad_perm:[3,3,3,3] row_mask:0xf bank_mask:0xf
    v_add_f32_dpp v117, v55, v117 quad_perm:[3,3,3,3] row_mask:0xf bank_mask:0xf
    v_add_f32_dpp v118, v59, v118 quad_perm:[3,3,3,3] row_mask:0xf bank_mask:0xf
    v_add_f32_dpp v119, v63, v119 quad_perm:[3,3,3,3] row_mask:0xf bank_mask:0xf
    v_cvt_pk_bf16_f32 v113, v112, v113
    v_cvt_pk_bf16_f32 v115, v114, v115
    v_cvt_pk_bf16_f32 v117, v116, v117
    v_cvt_pk_bf16_f32 v119, v118, v119
    v_lshlrev_b32 v112, 16, v113
    v_and_b32 v113, s29, v113
    v_lshlrev_b32 v114, 16, v115
    v_and_b32 v115, s29, v115
    v_lshlrev_b32 v116, 16, v117
    v_and_b32 v117, s29, v117
    v_lshlrev_b32 v118, 16, v119
    v_and_b32 v119, s29, v119
    v_pk_mul_f32 v[112:113], v[112:113], s[28:29] op_sel_hi:[1,0]
    v_pk_mul_f32 v[114:115], v[114:115], s[28:29] op_sel_hi:[1,0]
    v_pk_mul_f32 v[116:117], v[116:117], s[28:29] op_sel_hi:[1,0]
    v_pk_mul_f32 v[118:119], v[118:119], s[28:29] op_sel_hi:[1,0]
    v_cvt_pk_bf16_f32 v113, v112, v113
    v_cvt_pk_bf16_f32 v115, v114, v115
    v_cvt_pk_bf16_f32 v117, v116, v117
    v_cvt_pk_bf16_f32 v119, v118, v119
    v_lshlrev_b32 v112, 16, v113
    v_and_b32 v113, s29, v113
    v_lshlrev_b32 v114, 16, v115
    v_and_b32 v115, s29, v115
    v_lshlrev_b32 v116, 16, v117
    v_and_b32 v117, s29, v117
    v_lshlrev_b32 v118, 16, v119
    v_and_b32 v119, s29, v119
    v_max3_f32 v3, v112, v113, v114
    v_max3_f32 v3, v3, v115, v116
    v_max3_f32 v3, v3, v117, v118
    v_max_f32 v3, v3, v119
    v_mov_b32 v6, v3
    s_add_u32 s22, s22, 1
    s_and_b32 s23, s22, 0xfff
    v_permlane32_swap_b32 v3, v6
    s_cmp_eq_u32 s45, 2
    v_max_f32 v3, v3, v6
    v_mov_b32 v6, v3
    s_cselect_b64 s[46:47], s[18:19], s[20:21]
    s_nop 0
    v_permlane16_swap_b32 v3, v6
    s_nop 0
    v_max_f32 v3, v3, v6
    v_mul_f32 v3, s34, v3
    ds_write_b32 v11, v3 offset:3072
    v_fma_f32 v112, v112, s34, -v3
    v_fma_f32 v113, v113, s34, -v3
    v_fma_f32 v114, v114, s34, -v3
    v_fma_f32 v115, v115, s34, -v3
    v_fma_f32 v116, v116, s34, -v3
    v_fma_f32 v117, v117, s34, -v3
    v_fma_f32 v118, v118, s34, -v3
    v_fma_f32 v119, v119, s34, -v3
    v_exp_f32 v112, v112
    v_exp_f32 v113, v113
    v_exp_f32 v114, v114
    v_exp_f32 v115, v115
    v_exp_f32 v116, v116
    v_exp_f32 v117, v117
    v_exp_f32 v118, v118
    v_exp_f32 v119, v119
    v_cvt_pk_bf16_f32 v112, v112, v112
    v_cvt_pk_bf16_f32 v113, v113, v113
    v_cvt_pk_bf16_f32 v114, v114, v114
    v_cvt_pk_bf16_f32 v115, v115, v115
    v_cvt_pk_bf16_f32 v116, v116, v116
    v_cvt_pk_bf16_f32 v117, v117, v117
    v_cvt_pk_bf16_f32 v118, v118, v118
    v_cvt_pk_bf16_f32 v119, v119, v119
    v_and_b32 v32, v112, v4
    v_and_b32 v33, v112, v5
    v_and_b32 v34, v113, v4
    v_and_b32 v35, v113, v5
    v_and_b32 v36, v114, v4
    v_and_b32 v37, v114, v5
    v_and_b32 v38, v115, v4
    v_and_b32 v39, v115, v5
    v_and_b32 v40, v116, v4
    v_and_b32 v41, v116, v5
    v_and_b32 v42, v117, v4
    v_and_b32 v43, v117, v5
    v_and_b32 v44, v118, v4
    v_and_b32 v45, v118, v5
    v_and_b32 v46, v119, v4
    v_and_b32 v47, v119, v5
    v_mov_b32 v6, s23
    v_mfma_f32_16x16x32_bf16 v[48:51], v[32:35], v[120:123], 0
    v_mfma_f32_16x16x32_bf16 v[48:51], v[36:39], v[120:123], v[48:51]
    v_mfma_f32_16x16x32_bf16 v[48:51], v[40:43], v[120:123], v[48:51]
    v_mfma_f32_16x16x32_bf16 v[48:51], v[44:47], v[120:123], v[48:51]
    s_nop 7
    ds_write_b32 v7, v48 offset:3328
    ds_add_u32 v14, v15 offset:3204
    s_waitcnt vmcnt(2)
    v_add_u32 v30, s4, v2
    global_load_dwordx4 v[84:87], v30, s[8:9] nt
    s_add_u32 s4, s4, s5
    s_and_b32 s4, s4, s10
    v_mfma_f32_16x16x16_bf16 v[112:115], v[32:33], v[64:65], 0
    v_mfma_f32_16x16x16_bf16 v[116:119], v[32:33], v[66:67], 0
    v_mfma_f32_16x16x16_bf16 v[112:115], v[34:35], v[68:69], v[112:115]
    v_mfma_f32_16x16x16_bf16 v[116:119], v[34:35], v[70:71], v[116:119]
    v_mfma_f32_16x16x16_bf16 v[112:115], v[36:37], v[72:73], v[112:115]
    v_mfma_f32_16x16x16_bf16 v[116:119], v[36:37], v[74:75], v[116:119]
    s_waitcnt vmcnt(2)
    v_add_u32 v30, s4, v2
    global_load_dwordx4 v[88:91], v30, s[8:9] nt
    s_add_u32 s4, s4, s5
    s_and_b32 s4, s4, s10
    v_mfma_f32_16x16x16_bf16 v[112:115], v[38:39], v[76:77], v[112:115]
    v_mfma_f32_16x16x16_bf16 v[116:119], v[38:39], v[78:79], v[116:119]
    s_waitcnt vmcnt(2)
    v_add_u32 v30, s4, v2
    global_load_dwordx4 v[92:95], v30, s[8:9] nt
    s_add_u32 s4, s4, s5
    s_and_b32 s4, s4, s10
    v_mfma_f32_16x16x16_bf16 v[112:115], v[40:41], v[80:81], v[112:115]
    v_mfma_f32_16x16x16_bf16 v[116:119], v[40:41], v[82:83], v[116:119]
    s_waitcnt vmcnt(2)
    global_load_dwordx4 v[96:99], v22, s[12:13] offset:0 nt
    v_mfma_f32_16x16x16_bf16 v[112:115], v[42:43], v[84:85], v[112:115]
    v_mfma_f32_16x16x16_bf16 v[116:119], v[42:43], v[86:87], v[116:119]
    s_waitcnt vmcnt(2)
    global_load_dwordx4 v[100:103], v22, s[12:13] offset:1024 nt
    v_mfma_f32_16x16x16_bf16 v[112:115], v[44:45], v[88:89], v[112:115]
    v_mfma_f32_16x16x16_bf16 v[116:119], v[44:45], v[90:91], v[116:119]
    global_load_dwordx4 v[16:19], v9, s[46:47] offset:2560 sc1
    s_waitcnt vmcnt(3)
    v_mfma_f32_16x16x16_bf16 v[112:115], v[46:47], v[92:93], v[112:115]
    v_mfma_f32_16x16x16_bf16 v[116:119], v[46:47], v[94:95], v[116:119]
    s_mov_b32 s40, 2000000
    s_nop 5
    ds_write_b128 v10, v[112:115] offset:4096
    ds_write_b128 v10, v[116:119] offset:4112
    s_waitcnt lgkmcnt(0)
    s_barrier
    ds_read2st64_b32 v[64:65], v0 offset0:16 offset1:24
    ds_read2st64_b32 v[66:67], v0 offset0:32 offset1:40
    ds_read2st64_b32 v[68:69], v0 offset0:48 offset1:56
    ds_read2st64_b32 v[70:71], v0 offset0:64 offset1:72
    ds_read_b128 v[72:75], v12 offset:3456
    ds_read_b128 v[76:79], v12 offset:3472
    s_cmp_eq_u32 s45, 2
    s_waitcnt lgkmcnt(0)
    v_pk_mul_f32 v[64:65], v[64:65], v[72:73]
    v_pk_fma_f32 v[64:65], v[66:67], v[74:75], v[64:65]
    v_pk_fma_f32 v[64:65], v[68:69], v[76:77], v[64:65]
    v_pk_fma_f32 v[64:65], v[70:71], v[78:79], v[64:65]
    v_add_f32 v64, v64, v65
    v_add_u32 v64, 0x800, v64
    v_bfi_b32 v7, s37, v6, v64
    s_cbranch_scc0 L_oslow
    global_store_dword v13, v7, s[18:19] offset:0
L_osent:
    global_load_dwordx4 v[104:107], v22, s[12:13] offset:2048 nt
    global_load_dwordx4 v[108:111], v22, s[12:13] offset:3072 nt
    s_waitcnt vmcnt(3)
    s_branch L_lpoll_chk
L_lpoll:
    global_load_dwordx4 v[16:19], v9, s[46:47] offset:2560 sc1
    s_waitcnt vmcnt(0)
L_lpoll_chk:
    v_max_f32_dpp v19, v16, v16 row_ror:8 row_mask:0xf bank_mask:0xf
    v_xor_b32 v17, s22, v17
    v_xor_b32 v18, s22, v18
    v_max_f32_dpp v19, v19, v19 row_ror:4 row_mask:0xf bank_mask:0xf
    v_or_b32 v17, v17, v18
    v_cmp_ne_u32 vcc, 0, v17
    v_max_f32_dpp v19, v19, v19 row_ror:2 row_mask:0xf bank_mask:0xf
    s_sub_u32 s40, s40, 1
    s_cbranch_scc1 L_lpoll_done
    s_cbranch_vccnz L_lpoll
L_lpoll_done:
    v_max_f32_dpp v19, v19, v19 row_ror:1 row_mask:0xf bank_mask:0xf
    v_sub_f32 v16, v16, v19
    v_exp_f32 v16, v16
    s_nop 0
    s_mov_b32 s40, 2000000
    v_add_f32_dpp v17, v16, v16 row_ror:8 row_mask:0xf bank_mask:0xf
    s_nop 1
    v_add_f32_dpp v17, v17, v17 row_ror:4 row_mask:0xf bank_mask:0xf
    s_nop 1
    v_add_f32_dpp v17, v17, v17 row_ror:2 row_mask:0xf bank_mask:0xf
    s_nop 1
    v_add_f32_dpp v17, v17, v17 row_ror:1 row_mask:0xf bank_mask:0xf
    v_rcp_f32 v17, v17
    s_waitcnt vmcnt(3)
    v_mul_f32 v16, v16, v17
    v_perm_b32 v32, v100, v96, s38
    v_perm_b32 v33, v100, v96, s39
    v_perm_b32 v34, v101, v97, s38
    v_perm_b32 v35, v101, v97, s39
    v_perm_b32 v36, v102, v98, s38
    v_perm_b32 v37, v102, v98, s39
    v_perm_b32 v38, v103, v99, s38
    v_perm_b32 v39, v103, v99, s39
    s_waitcnt vmcnt(1)
    global_load_dwordx4 v[64:67], v8, s[46:47] offset:0 sc1
    s_waitcnt vmcnt(1)
    v_perm_b32 v40, v108, v104, s38
    v_perm_b32 v41, v108, v104, s39
    v_perm_b32 v42, v109, v105, s38
    v_perm_b32 v43, v109, v105, s39
    v_perm_b32 v44, v110, v106, s38
    v_perm_b32 v45, v110, v106, s39
    v_perm_b32 v46, v111, v107, s38
    v_perm_b32 v47, v111, v107, s39
    s_branch L_opoll_chk
L_opoll:
    global_load_dwordx4 v[64:67], v8, s[46:47] offset:0 sc1
L_opoll_chk:
    s_waitcnt vmcnt(0)
    v_xor_b32 v64, s23, v64
    v_xor_b32 v65, s23, v65
    v_xor_b32 v66, s23, v66
    v_xor_b32 v67, s23, v67
    v_or3_b32 v3, v64, v65, v66
    v_or_b32 v3, v3, v67
    v_and_b32 v3, s37, v3
    v_cmp_ne_u32 vcc, 0, v3
    v_pk_mul_f32 v[64:65], v[64:65], v[16:17] op_sel_hi:[1,0]
    v_pk_mul_f32 v[66:67], v[66:67], v[16:17] op_sel_hi:[1,0]
    s_sub_u32 s40, s40, 1
    s_cbranch_scc1 L_opoll_done
    s_cbranch_vccnz L_opoll
L_opoll_done:
    v_add_f32_dpp v64, v64, v64 row_ror:8 row_mask:0xf bank_mask:0xf
    v_add_f32_dpp v65, v65, v65 row_ror:8 row_mask:0xf bank_mask:0xf
    v_add_f32_dpp v66, v66, v66 row_ror:8 row_mask:0xf bank_mask:0xf
    v_add_f32_dpp v67, v67, v67 row_ror:8 row_mask:0xf bank_mask:0xf
    v_add_f32_dpp v64, v64, v64 row_ror:4 row_mask:0xf bank_mask:0xf
    v_add_f32_dpp v65, v65, v65 row_ror:4 row_mask:0xf bank_mask:0xf
    v_add_f32_dpp v66, v66, v66 row_ror:4 row_mask:0xf bank_mask:0xf
    v_add_f32_dpp v67, v67, v67 row_ror:4 row_mask:0xf bank_mask:0xf
    v_add_f32_dpp v64, v64, v64 row_ror:2 row_mask:0xf bank_mask:0xf
    v_add_f32_dpp v65, v65, v65 row_ror:2 row_mask:0xf bank_mask:0xf
    v_add_f32_dpp v66, v66, v66 row_ror:2 row_mask:0xf bank_mask:0xf
    v_add_f32_dpp v67, v67, v67 row_ror:2 row_mask:0xf bank_mask:0xf
    v_add_f32_dpp v64, v64, v64 row_ror:1 row_mask:0xf bank_mask:0xf
    v_add_f32_dpp v65, v65, v65 row_ror:1 row_mask:0xf bank_mask:0xf
    v_add_f32_dpp v66, v66, v66 row_ror:1 row_mask:0xf bank_mask:0xf
    v_add_f32_dpp v67, v67, v67 row_ror:1 row_mask:0xf bank_mask:0xf
    v_cvt_pk_bf16_f32 v64, v64, v65
    v_cvt_pk_bf16_f32 v65, v66, v67
    v_dot2_f32_bf16 v120, v64, v32, 0
    v_dot2_f32_bf16 v121, v64, v33, 0
    v_dot2_f32_bf16 v122, v64, v34, 0
    v_dot2_f32_bf16 v123, v64, v35, 0
    v_dot2_f32_bf16 v124, v64, v36, 0
    v_dot2_f32_bf16 v125, v64, v37, 0
    v_dot2_f32_bf16 v126, v64, v38, 0
    v_dot2_f32_bf16 v127, v64, v39, 0
    v_dot2_f32_bf16 v120, v65, v40, v120
    v_dot2_f32_bf16 v121, v65, v41, v121
    v_dot2_f32_bf16 v122, v65, v42, v122
    v_dot2_f32_bf16 v123, v65, v43, v123
    v_dot2_f32_bf16 v124, v65, v44, v124
    v_dot2_f32_bf16 v125, v65, v45, v125
    v_dot2_f32_bf16 v126, v65, v46, v126
    v_dot2_f32_bf16 v127, v65, v47, v127
    ds_write_b128 v23, v[120:123] offset:20480
    s_nop 1
    ds_write_b128 v23, v[124:127] offset:20496
    s_waitcnt lgkmcnt(0)
    s_barrier
    ds_read2st64_b32 v[64:65], v24 offset0:80 offset1:89
    ds_read2st64_b32 v[66:67], v24 offset0:98 offset1:107
    ds_read2st64_b32 v[68:69], v24 offset0:116 offset1:125
    ds_read2st64_b32 v[70:71], v24 offset0:134 offset1:143
    s_waitcnt lgkmcnt(0)
    v_pk_add_f32 v[64:65], v[64:65], v[66:67]
    v_pk_add_f32 v[68:69], v[68:69], v[70:71]
    v_pk_add_f32 v[64:65], v[64:65], v[68:69]
    v_add_f32 v64, v64, v65
    s_nop 1
    v_add_f32_dpp v64, v64, v64 quad_perm:[1,0,3,2] row_mask:0xf bank_mask:0xf
    s_mov_b32 s35, 0x33333333
    s_mov_b32 s36, 0x41f80000
    v_add_f32_dpp v64, v64, v64 quad_perm:[2,3,0,1] row_mask:0xf bank_mask:0xf
    s_mov_b32 exec_lo, s35
    s_mov_b32 exec_hi, s35
    v_cndmask_b32 v64, v64, 1.0, s[30:31]
    global_atomic_add_f32 v65, v1, v64, s[20:21] sc0
    s_waitcnt vmcnt(0)
    v_mov_b32_dpp v66, v65 quad_perm:[1,0,3,2] row_mask:0xf bank_mask:0xf
    v_add_f32 v64, v64, v65
    v_cmp_eq_f32 vcc, s36, v66
    v_cvt_pk_bf16_f32 v64, v64, v64
    s_andn2_b64 exec, vcc, s[30:31]
    s_cbranch_execz L_fin
    global_store_short v26, v64, s[16:17]
    s_or_b32 s36, s43, s41
    s_cbranch_scc1 L_fin
    v_mov_b32 v3, s33
    v_mov_b32 v4, s22
    global_store_dword v3, v4, s[20:21]
    s_branch L_fin
L_oslow:
    global_store_dword v13, v7, s[20:21] offset:0 sc1
    s_branch L_osent
L_q2:
    s_setprio 3
    v_and_b32 v8, 0x30, v2
    s_mov_b64 s[28:29], 0xffff
    v_lshlrev_b64 v[4:5], v8, s[28:29]
    s_mov_b32 s35, 0x01000100
    s_mov_b32 s36, 0x03020302
    s_lshl_b32 s37, s3, 9
    v_lshl_add_u32 v10, v1, 5, s37
    s_and_b32 s26, s2, 15
    s_mul_i32 s26, s26, 47104
    s_add_u32 s26, s26, 65536
    s_mul_i32 s27, s24, 2944
    s_add_u32 s27, s27, s26
    s_add_u32 s18, s20, 786432
    s_addc_u32 s19, s21, 0
    v_lshlrev_b32 v8, 3, v1
    v_add_u32 v72, s27, v8
    s_add_u32 s39, s26, 14336
    s_lshl_b32 s38, s24, 2
    s_add_u32 s38, s38, s39
    v_mov_b32 v73, s38
    s_getreg_b32 s44, hwreg(HW_REG_XCC_ID, 0, 4)
    s_lshl_b32 s44, s44, 24
    v_and_b32 v6, 48, v1
    v_and_b32 v9, 15, v1
    v_lshl_add_u32 v74, v9, 2, s39
    v_lshl_add_u32 v9, v9, 5, s26
    v_mul_u32_u24 v7, 184, v6
    v_add_u32 v76, v7, v9
    v_add_u32 v77, 11776, v76
    v_add_u32 v78, 23552, v76
    v_add_u32 v79, 35328, v76
    s_lshl_b32 s38, s24, 4
    s_add_u32 s38, s38, s26
    v_add_u32 v7, s38, v7
    v_and_b32 v9, 7, v1
    v_lshlrev_b32 v9, 2, v9
    v_lshl_add_u32 v9, v6, 1, v9
    v_add_u32 v9, 3072, v9
    s_waitcnt vmcnt(8)
    v_perm_b32 v3, v12, v12, s35
    v_and_b32 v48, v3, v4
    v_and_b32 v49, v3, v5
    v_perm_b32 v3, v12, v12, s36
    v_and_b32 v50, v3, v4
    v_and_b32 v51, v3, v5
    v_perm_b32 v3, v13, v13, s35
    v_and_b32 v52, v3, v4
    v_and_b32 v53, v3, v5
    v_perm_b32 v3, v13, v13, s36
    v_and_b32 v54, v3, v4
    v_and_b32 v55, v3, v5
    v_perm_b32 v3, v14, v14, s35
    v_and_b32 v56, v3, v4
    v_and_b32 v57, v3, v5
    v_perm_b32 v3, v14, v14, s36
    v_and_b32 v58, v3, v4
    v_and_b32 v59, v3, v5
    v_perm_b32 v3, v15, v15, s35
    v_and_b32 v60, v3, v4
    v_and_b32 v61, v3, v5
    v_perm_b32 v3, v15, v15, s36
    v_and_b32 v62, v3, v4
    v_and_b32 v63, v3, v5
    v_mov_b32 v13, 0
    v_mov_b32 v14, 1
    s_movk_i32 s37, 0xfff
    s_waitcnt lgkmcnt(0)
    s_add_u32 s22, s22, 1
    s_and_b32 s23, s22, 0xfff
    s_xor_b32 s44, s44, s22
    v_mov_b32 v15, s23
    v_mov_b32 v80, s44
    v_mov_b32 v85, s22
    v_mov_b32 v86, s22
    v_mov_b32 v87, s22
    s_waitcnt vmcnt(7)
    v_mfma_f32_16x16x16_bf16 v[64:67], v[48:49], v[16:17], 0
    v_mfma_f32_16x16x16_bf16 v[68:71], v[48:49], v[18:19], 0
    s_waitcnt vmcnt(6)
    v_mfma_f32_16x16x16_bf16 v[64:67], v[50:51], v[20:21], v[64:67]
    v_mfma_f32_16x16x16_bf16 v[68:71], v[50:51], v[22:23], v[68:71]
    s_waitcnt vmcnt(5)
    v_mfma_f32_16x16x16_bf16 v[64:67], v[52:53], v[24:25], v[64:67]
    v_mfma_f32_16x16x16_bf16 v[68:71], v[52:53], v[26:27], v[68:71]
    s_waitcnt vmcnt(4)
    v_mfma_f32_16x16x16_bf16 v[64:67], v[54:55], v[28:29], v[64:67]
    v_mfma_f32_16x16x16_bf16 v[68:71], v[54:55], v[30:31], v[68:71]
    s_waitcnt vmcnt(3)
    v_mfma_f32_16x16x16_bf16 v[64:67], v[56:57], v[32:33], v[64:67]
    v_mfma_f32_16x16x16_bf16 v[68:71], v[56:57], v[34:35], v[68:71]
    s_waitcnt vmcnt(2)
    v_mfma_f32_16x16x16_bf16 v[64:67], v[58:59], v[36:37], v[64:67]
    v_mfma_f32_16x16x16_bf16 v[68:71], v[58:59], v[38:39], v[68:71]
    s_waitcnt vmcnt(1)
    v_mfma_f32_16x16x16_bf16 v[64:67], v[60:61], v[40:41], v[64:67]
    v_mfma_f32_16x16x16_bf16 v[68:71], v[60:61], v[42:43], v[68:71]
    s_waitcnt vmcnt(0)
    v_mfma_f32_16x16x16_bf16 v[64:67], v[62:63], v[44:45], v[64:67]
    v_mfma_f32_16x16x16_bf16 v[68:71], v[62:63], v[46:47], v[68:71]
    s_mov_b64 exec, 0xffff
    s_cmp_eq_u32 s3, 0
    s_nop 4
    ds_write_b128 v10, v[64:67] offset:0
    ds_write_b128 v10, v[68:71] offset:16
    ds_add_u32 v13, v14 offset:3212
    s_mov_b64 exec, -1
    s_cbranch_scc1 L_comm
    s_cmp_eq_u32 s3, 1
    s_cbranch_scc1 L_zero
    s_endpgm
L_zero:
    s_cmp_lg_u32 s25, 0
    s_cbranch_scc1 L_fin
    s_lshl_b32 s36, s24, 3
    s_add_u32 s36, s36, s33
    v_mov_b32 v3, s36
    global_store_dwordx2 v3, v[86:87], s[20:21] offset:2048 sc1
    s_endpgm
L_comm:
    s_mov_b32 s40, 2000000
L_cq:
    ds_read_b32 v3, v13 offset:3212
    ds_read_b64 v[16:17], v8 offset:0
    ds_read_b64 v[18:19], v8 offset:512
    ds_read_b64 v[20:21], v8 offset:1024
    ds_read_b64 v[22:23], v8 offset:1536
    s_sub_u32 s40, s40, 1
    s_cbranch_scc1 L_cq_done
    s_waitcnt lgkmcnt(0)
    v_cmp_gt_u32 vcc, 64, v3
    s_cbranch_vccz L_cq_done
    s_sleep 0
    s_branch L_cq
L_cq_done:
    v_pk_add_f32 v[16:17], v[16:17], v[18:19]
    v_pk_add_f32 v[20:21], v[20:21], v[22:23]
    v_pk_add_f32 v[16:17], v[16:17], v[20:21]
    v_add_u32 v16, 0x800, v16
    v_add_u32 v17, 0x800, v17
    v_bfi_b32 v82, s37, v15, v16
    v_bfi_b32 v83, s37, v15, v17
    global_store_dwordx2 v72, v[82:83], s[18:19] offset:2048
    s_mov_b64 exec, 1
    global_store_dword v73, v80, s[18:19]
    s_mov_b64 exec, -1
    s_mov_b32 s40, 2000000
    v_mov_b32 v14, 2
    v_mov_b32 v81, 2
    s_mov_b64 s[46:47], s[18:19]
    s_waitcnt vmcnt(0)
L_qpoll:
    global_load_dword v63, v74, s[18:19] sc1
    global_load_dwordx4 v[16:19], v76, s[46:47] offset:2048 sc1
    global_load_dwordx4 v[20:23], v76, s[46:47] offset:2064 sc1
    global_load_dwordx4 v[24:27], v77, s[46:47] offset:2048 sc1
    global_load_dwordx4 v[28:31], v77, s[46:47] offset:2064 sc1
    global_load_dwordx4 v[32:35], v78, s[46:47] offset:2048 sc1
    global_load_dwordx4 v[36:39], v78, s[46:47] offset:2064 sc1
    global_load_dwordx4 v[40:43], v79, s[46:47] offset:2048 sc1
    global_load_dwordx4 v[44:47], v79, s[46:47] offset:2064 sc1
    s_sub_u32 s40, s40, 1
    s_cbranch_scc1 L_qpoll_done
    s_cmp_lt_u32 s40, 1999988
    s_cbranch_scc1 L_hint_ask
L_hint_chk:
    s_waitcnt vmcnt(8)
    v_xor_b32 v48, s44, v63
L_qchk:
    s_waitcnt vmcnt(0)
    v_xor_b32 v16, s23, v16
    v_xor_b32 v17, s23, v17
    v_xor_b32 v18, s23, v18
    v_xor_b32 v19, s23, v19
    v_xor_b32 v20, s23, v20
    v_xor_b32 v21, s23, v21
    v_xor_b32 v22, s23, v22
    v_xor_b32 v23, s23, v23
    v_xor_b32 v24, s23, v24
    v_xor_b32 v25, s23, v25
    v_xor_b32 v26, s23, v26
    v_xor_b32 v27, s23, v27
    v_xor_b32 v28, s23, v28
    v_xor_b32 v29, s23, v29
    v_xor_b32 v30, s23, v30
    v_xor_b32 v31, s23, v31
    v_xor_b32 v32, s23, v32
    v_xor_b32 v33, s23, v33
    v_xor_b32 v34, s23, v34
    v_xor_b32 v35, s23, v35
    v_xor_b32 v36, s23, v36
    v_xor_b32 v37, s23, v37
    v_xor_b32 v38, s23, v38
    v_xor_b32 v39, s23, v39
    v_xor_b32 v40, s23, v40
    v_xor_b32 v41, s23, v41
    v_xor_b32 v42, s23, v42
    v_xor_b32 v43, s23, v43
    v_xor_b32 v44, s23, v44
    v_xor_b32 v45, s23, v45
    v_xor_b32 v46, s23, v46
    v_xor_b32 v47, s23, v47
    v_or_b32 v63, v16, v17
    v_or3_b32 v63, v63, v18, v19
    v_or3_b32 v63, v63, v20, v21
    v_or3_b32 v63, v63, v22, v23
    v_or3_b32 v63, v63, v24, v25
    v_or3_b32 v63, v63, v26, v27
    v_or3_b32 v63, v63, v28, v29
    v_or3_b32 v63, v63, v30, v31
    v_or3_b32 v63, v63, v32, v33
    v_or3_b32 v63, v63, v34, v35
    v_or3_b32 v63, v63, v36, v37
    v_or3_b32 v63, v63, v38, v39
    v_or3_b32 v63, v63, v40, v41
    v_or3_b32 v63, v63, v42, v43
    v_or3_b32 v63, v63, v44, v45
    v_or3_b32 v63, v63, v46, v47
    v_and_or_b32 v48, v63, s37, v48
    v_cmp_ne_u32 vcc, 0, v48
    s_cbranch_vccnz L_qpoll
L_qpoll_done:
    v_pk_add_f32 v[16:17], v[16:17], v[32:33]
    v_pk_add_f32 v[18:19], v[18:19], v[34:35]
    v_pk_add_f32 v[20:21], v[20:21], v[36:37]
    v_pk_add_f32 v[22:23], v[22:23], v[38:39]
    v_pk_add_f32 v[24:25], v[24:25], v[40:41]
    v_pk_add_f32 v[26:27], v[26:27], v[42:43]
    v_pk_add_f32 v[28:29], v[28:29], v[44:45]
    v_pk_add_f32 v[30:31], v[30:31], v[46:47]
    v_pk_add_f32 v[16:17], v[16:17], v[24:25]
    v_pk_add_f32 v[18:19], v[18:19], v[26:27]
    v_pk_add_f32 v[20:21], v[20:21], v[28:29]
    v_pk_add_f32 v[22:23], v[22:23], v[30:31]
    v_cvt_pk_bf16_f32 v16, v16, v17
    v_cvt_pk_bf16_f32 v17, v18, v19
    v_cvt_pk_bf16_f32 v18, v20, v21
    v_cvt_pk_bf16_f32 v19, v22, v23
    ds_write_b128 v2, v[16:19] offset:2048
    ds_write_b32 v13, v14 offset:3200
    v_and_b32 v30, 0x7c, v8
    v_add_u32 v30, s33, v30
    s_mov_b32 s40, 2000000
L_zpoll:
    global_load_dwordx2 v[28:29], v30, s[20:21] offset:2048 sc1
    s_waitcnt vmcnt(0)
    v_cmp_ne_u64 vcc, v[28:29], v[86:87]
    s_sub_u32 s40, s40, 1
    s_cbranch_scc1 L_zpoll_done
    s_cbranch_vccnz L_zpoll
L_zpoll_done:
    s_mov_b32 s40, 2000000
L_cpoll:
    ds_read_b32 v3, v13 offset:3204
    ds_read2_b32 v[16:17], v9 offset0:0 offset1:64
    s_sub_u32 s40, s40, 1
    s_cbranch_scc1 L_cpoll_done
    s_waitcnt lgkmcnt(0)
    v_cmp_gt_u32 vcc, 512, v3
    s_cbranch_vccz L_cpoll_done
    s_sleep 1
    s_branch L_cpoll
L_cpoll_done:
    v_max_f32_dpp v18, v16, v16 row_ror:4 row_mask:0xf bank_mask:0xf
    s_nop 1
    v_max_f32_dpp v18, v18, v18 row_ror:2 row_mask:0xf bank_mask:0xf
    s_nop 1
    v_max_f32_dpp v18, v18, v18 row_ror:1 row_mask:0xf bank_mask:0xf
    v_sub_f32 v16, v16, v18
    v_exp_f32 v16, v16
    s_nop 0
    v_mul_f32 v17, v17, v16
    s_nop 1
    v_add_f32_dpp v17, v17, v17 row_ror:4 row_mask:0xf bank_mask:0xf
    s_nop 1
    v_add_f32_dpp v17, v17, v17 row_ror:2 row_mask:0xf bank_mask:0xf
    s_nop 1
    v_add_f32_dpp v17, v17, v17 row_ror:1 row_mask:0xf bank_mask:0xf
    v_rcp_f32 v19, v17
    v_log_f32 v17, v17
    v_mul_f32 v16, v16, v19
    ds_write_b32 v9, v16 offset:384
    v_add_f32 v84, v17, v18
    s_mov_b32 exec_lo, 0x00010001
    s_mov_b32 exec_hi, 0x00010001
    s_cmp_eq_u32 s46, s18
    s_cbranch_scc0 L_lslow
    global_store_dwordx4 v7, v[84:87], s[18:19] offset:2560
L_lsent:
    s_mov_b64 exec, -1
    s_waitcnt lgkmcnt(0)
    s_barrier
L_fin:
L_end:
    s_endpgm
L_hint_ask:
    v_mov_b32 v48, 0
    s_cmp_eq_u32 s46, s20
    s_cbranch_scc1 L_qchk
    global_store_dword v73, v80, s[20:21] sc1
    global_load_dword v48, v74, s[20:21] sc1
    s_waitcnt vmcnt(0)
    v_xor_b32 v48, v48, v80
    v_alignbit_b32 v48, v48, v48, 24
    v_subrev_u32 v48, 1, v48
    v_cmp_gt_u32 vcc, 15, v48
    s_cbranch_vccz L_hint_chk
    global_store_dwordx2 v72, v[82:83], s[20:21] offset:2048 sc1
    v_mov_b32 v14, 1
    s_mov_b64 s[46:47], s[20:21]
    s_branch L_qpoll
L_lslow:
    global_store_dwordx4 v7, v[84:87], s[20:21] offset:2560 sc1
    s_branch L_lsent
.section .rodata,"a"
.p2align 6
.amdhsa_kernel concat_heads__sliding_block_cached__sliding_block_cached__decode_kernel
  .amdhsa_next_free_vgpr 128
  .amdhsa_next_free_sgpr 48
  .amdhsa_accum_offset 128
  .amdhsa_group_segment_fixed_size 0
  .amdhsa_kernarg_size 104
  .amdhsa_user_sgpr_count 2
  .amdhsa_user_sgpr_kernarg_segment_ptr 1
  .amdhsa_system_sgpr_workgroup_id_x 1
  .amdhsa_float_denorm_mode_32 3
.end_amdhsa_kernel
```
